```python
import torch

def _softmax(x, axis=-1):
    return torch.softmax(x, dim=axis)
def _gelu(x):
    return torch.nn.functional.gelu(x, approximate="tanh")
def _silu(x):
    return torch.nn.functional.silu(x)
def _sigmoid(x):
    return torch.sigmoid(x)
def _layernorm(x, axis=-1, eps=1e-5):
    m = x.mean(dim=axis, keepdim=True)
    v = x.var(dim=axis, keepdim=True, unbiased=False)
    return (x - m) / torch.sqrt(v + eps)
def _scatter_add(tgt, idx, src, axis=0):
    return tgt.clone().index_add_(axis, idx, src)
def _segment_sum(src, seg, n):
    out = torch.zeros((n,) + src.shape[1:], dtype=src.dtype)
    return out.index_add_(0, seg, src)
def _pad(x, pw):
    flat = tuple(v for pair in reversed(pw) for v in pair)
    return torch.nn.functional.pad(x, flat)

kernel_name = 'standalone__paged_block_table_kv_radixattention__decode'

def setup_inputs():

    _w = (lambda a: (lambda t: t.to(torch.bfloat16) if t.is_floating_point() else t)(torch.as_tensor(a)))
    B, H, Hkv, Dh = 2, 32, 16, 128
    Lk = 4096
    bs = 16
    nb = max(2, Lk // bs)
    P = max(1, nb // 2)
    n_phys = P + B * (nb - P)
    shared = torch.arange(P, dtype=torch.int64)
    priv = P + torch.arange(B * (nb - P), dtype=torch.int64).reshape(B, nb - P)
    bt = torch.cat([torch.tile(shared[None, :], (B, 1)), priv], dim=1)
    ctx = nb * bs - (torch.arange(1, B + 1, dtype=torch.int64) * 2654435761) % max(1, (nb * bs - P * bs) // 2)
    return {
        "q": _w((lambda *s: torch.randn(*s, dtype=torch.bfloat16) * 0.8)(B, H, Dh)),
        "k_cache": _w((lambda *s: torch.randn(*s, dtype=torch.bfloat16) * 0.8)(n_phys, bs, Hkv, Dh)),
        "v_cache": _w((lambda *s: torch.randn(*s, dtype=torch.bfloat16) * 0.05)(n_phys, bs, Hkv, Dh)),
        "block_table": _w(bt.to(torch.int64)),
        "ctx_lens": _w(torch.as_tensor(ctx).to(torch.int64)),
    }

def reference(q, k_cache, v_cache, block_table, ctx_lens):
    B, H, Dh = q.shape
    n_phys, bs, Hkv, _ = k_cache.shape
    nb = block_table.shape[1]
    Lk = nb * bs
    rep = H // Hkv
    k = k_cache[block_table].reshape(B, Lk, Hkv, Dh)
    v = v_cache[block_table].reshape(B, Lk, Hkv, Dh)
    k = (lambda x, n, axis: torch.repeat_interleave(x, n, dim=axis))(k, rep, axis=2)
    v = (lambda x, n, axis: torch.repeat_interleave(x, n, dim=axis))(v, rep, axis=2)
    scores = torch.einsum("bhd,bkhd->bhk", q, k) * (Dh ** -0.5)
    pos = torch.arange(Lk)
    valid = pos[None, :] < ctx_lens[:, None]
    scores = torch.where(valid[:, None, :], scores, -1e9)
    p = _softmax(scores, axis=-1)
    return torch.einsum("bhk,bkhd->bhd", p, v)
```

```asm
; @launch grid=(256,1,1) block=(512,1,1) lds=132608
.amdgcn_target "amdgcn-amd-amdhsa--gfx950"
.text
.globl standalone__paged_block_table_kv_radixattention__decode_kernel
.p2align 12
.type standalone__paged_block_table_kv_radixattention__decode_kernel,@function
standalone__paged_block_table_kv_radixattention__decode_kernel:
    s_load_dwordx2 s[20:21], s[0:1], 8
    s_load_dwordx16 s[4:19], s[0:1], 0
    s_setprio 3
    s_cmp_ge_u32 s2, 256
    s_cbranch_scc1 L_end
    s_getpc_b64 s[78:79]
    v_cmp_gt_u32 vcc, 32, v0
    v_lshlrev_b32 v19, 7, v0
    s_and_b32 s78, s78, 0xfffff000
    s_and_b64 exec, exec, vcc
    s_cbranch_execz L_nocpf
    global_load_dword v204, v19, s[78:79] offset:1024
L_nocpf:
    s_mov_b64 exec, -1
    v_lshrrev_b32 v18, 6, v0
    v_and_b32 v0, 63, v0
    s_lshr_b32 s40, s2, 4
    v_readfirstlane_b32 s3, v18
    s_mov_b32 s54, 0xca742f91
    s_mov_b32 s55, 0xeb8630d5
    s_lshl_b32 s41, s2, 2
    s_lshr_b64 s[54:55], s[54:55], s41
    s_and_b32 s41, s54, 15
    v_lshlrev_b32 v195, 2, v0
    v_add_u32 v18, 131072, v195
    v_mov_b32 v164, -1
    ds_write_b32 v18, v164
    v_and_b32 v191, 15, v0
    v_lshrrev_b32 v192, 4, v0
    s_lshl_b32 s42, s41, 8
    v_xor_b32 v99, v191, v192
    s_lshl_b32 s43, s3, 4
    v_lshlrev_b32 v99, 4, v99
    s_add_u32 s43, s43, s40
    v_lshl_or_b32 v1, v192, 12, v99
    v_xor_b32 v2, 0x4040, v1
    s_pack_ll_b32_b16 s75, s42, s43
    v_xor_b32 v3, 0x8080, v1
    s_lshl_b32 s49, s3, 14
    v_xor_b32 v4, 0xc0c0, v1
    s_add_u32 m0, s49, 12288
    v_subrev_u32 v2, 1024, v2
    s_mov_b32 s22, 25165824
    v_subrev_u32 v3, 2048, v3
    s_mov_b32 s23, 0x20000
    v_subrev_u32 v4, 3072, v4
    s_lshl_b32 s44, s40, 3
    s_add_u32 s44, s44, s3
    s_cmp_lg_u32 s44, 1
    s_cselect_b32 s39, 1, 0
    s_cbranch_scc1 L_noclr
    v_mov_b32 v165, -1
    v_mov_b32 v166, -1
    v_mov_b32 v167, -1
    s_getreg_b32 s74, hwreg(HW_REG_XCC_ID, 0, 4)
    s_or_b32 s74, s74, 0x10
    v_mov_b32 v19, s74
    s_lshl_b32 s38, s41, 11
    s_add_u32 s38, s38, 524288
    v_lshl_add_u32 v18, v0, 4, s38
    s_waitcnt lgkmcnt(0)
    global_store_dwordx4 v18, v[164:167], s[18:19] sc1
    global_store_dwordx4 v18, v[164:167], s[18:19] offset:1024 sc1
    s_barrier
    v_lshl_add_u32 v18, v0, 5, s38
    s_lshl_b32 s38, s41, 4
    v_mov_b32 v190, s38
    s_mov_b64 exec, 1
    s_waitcnt vmcnt(0)
    global_store_dword v190, v19, s[16:17] sc1
    s_mov_b64 exec, -1
    global_load_dword v204, v18, s[18:19] sc1
L_noclr:
    s_waitcnt lgkmcnt(0)
    buffer_load_dwordx4 v1, s[20:23], s75 offen offset:0 nt lds
    buffer_load_dwordx4 v2, s[20:23], s75 offen offset:1024 nt lds
    buffer_load_dwordx4 v3, s[20:23], s75 offen offset:2048 nt lds
    buffer_load_dwordx4 v4, s[20:23], s75 offen offset:3072 nt lds
    s_lshl_b32 s45, s43, 4
    s_sub_u32 s48, 4080, s45
    s_add_u32 s47, s45, 2048
    s_sub_u32 s46, 2032, s45
    s_load_dwordx2 s[50:51], s[12:13], 0
    s_lshr_b32 s62, s45, 2
    s_load_dword s54, s[10:11], s62 offset:0
    s_load_dword s55, s[10:11], s62 offset:1024
    s_lshr_b32 s63, s47, 2
    s_load_dword s56, s[10:11], s63 offset:0
    s_load_dword s57, s[10:11], s63 offset:1024
    s_lshr_b32 s64, s46, 2
    s_load_dword s58, s[10:11], s64 offset:0
    s_load_dword s59, s[10:11], s64 offset:1024
    s_lshr_b32 s65, s48, 2
    s_load_dword s60, s[10:11], s65 offset:0
    s_load_dword s61, s[10:11], s65 offset:1024
    s_mov_b32 s26, 25165824
    s_mov_b32 s27, 0x20000
    s_mov_b32 s34, 3145728
    s_mov_b32 s35, 0x20000
    s_mov_b32 s30, 16384
    s_mov_b32 s31, 0x20000
    v_lshlrev_b32 v203, 4, v0
    s_mov_b64 s[32:33], s[18:19]
    s_mov_b64 s[28:29], s[4:5]
    s_mov_b64 s[24:25], s[8:9]
    s_getreg_b32 s74, hwreg(HW_REG_XCC_ID, 0, 4)
    s_or_b32 s74, s74, 0x10
    s_lshl_b32 s38, s41, 4
    v_mov_b32 v190, s38
    v_and_b32 v17, 0x1f0, v203
    v_lshrrev_b32 v18, 5, v0
    v_lshl_or_b32 v17, v18, 13, v17
    s_lshl_b32 s36, s41, 9
    v_lshlrev_b32 v5, 4, v191
    v_lshl_or_b32 v5, v192, 14, v5
    v_or_b32 v6, 0x1000, v5
    v_or_b32 v7, 0x2000, v5
    v_or_b32 v8, 0x3000, v5
    s_cmp_eq_u32 s39, 0
    s_cbranch_scc1 L_nobar
    s_barrier
L_nobar:
    s_waitcnt lgkmcnt(0)
    s_sub_u32 s52, s50, 1
    s_min_u32 s52, s52, 4095
    s_pack_ll_b32_b16 s65, s42, s54
    s_cmp_le_i32 s45, s52
    s_cselect_b32 s73, 1, 0
    s_cbranch_scc0 L_kskip3
    s_cmp_eq_u32 s65, s75
    s_cbranch_scc1 L_kskip3
    s_waitcnt vmcnt(0)
    buffer_load_dwordx4 v1, s[20:23], s65 offen offset:0 nt lds
    buffer_load_dwordx4 v2, s[20:23], s65 offen offset:1024 nt lds
    buffer_load_dwordx4 v3, s[20:23], s65 offen offset:2048 nt lds
    buffer_load_dwordx4 v4, s[20:23], s65 offen offset:3072 nt lds
L_kskip3:
    s_add_u32 m0, s49, 8192
    s_pack_ll_b32_b16 s64, s42, s56
    s_cmp_le_i32 s47, s52
    s_cselect_b32 s72, 1, 0
    s_cbranch_scc0 L_kskip2
    buffer_load_dwordx4 v1, s[20:23], s64 offen offset:0 nt lds
    buffer_load_dwordx4 v2, s[20:23], s64 offen offset:1024 nt lds
    buffer_load_dwordx4 v3, s[20:23], s64 offen offset:2048 nt lds
    buffer_load_dwordx4 v4, s[20:23], s64 offen offset:3072 nt lds
L_kskip2:
    s_add_u32 m0, s49, 4096
    s_sub_u32 s53, s51, 1
    s_min_u32 s53, s53, 4095
    s_pack_ll_b32_b16 s63, s42, s61
    s_cmp_eq_u32 s60, s61
    s_cselect_b32 s43, s52, -1
    s_cmp_gt_i32 s48, s43
    s_cselect_b32 s43, s53, -1
    s_cmp_le_i32 s48, s43
    s_cselect_b32 s71, 1, 0
    s_cbranch_scc0 L_kskip1
    buffer_load_dwordx4 v1, s[20:23], s63 offen offset:0 nt lds
    buffer_load_dwordx4 v2, s[20:23], s63 offen offset:1024 nt lds
    buffer_load_dwordx4 v3, s[20:23], s63 offen offset:2048 nt lds
    buffer_load_dwordx4 v4, s[20:23], s63 offen offset:3072 nt lds
L_kskip1:
    s_add_u32 m0, s49, 0
    s_pack_ll_b32_b16 s62, s42, s59
    s_cmp_eq_u32 s58, s59
    s_cselect_b32 s43, s52, -1
    s_cmp_gt_i32 s46, s43
    s_cselect_b32 s43, s53, -1
    s_cmp_le_i32 s46, s43
    s_cselect_b32 s70, 1, 0
    s_cbranch_scc0 L_kskip0
    buffer_load_dwordx4 v1, s[20:23], s62 offen offset:0 nt lds
    buffer_load_dwordx4 v2, s[20:23], s62 offen offset:1024 nt lds
    buffer_load_dwordx4 v3, s[20:23], s62 offen offset:2048 nt lds
    buffer_load_dwordx4 v4, s[20:23], s62 offen offset:3072 nt lds
L_kskip0:
    s_mov_b32 m0, 131584
    s_nop 0
    buffer_load_dwordx4 v17, s[28:31], s36 offen lds
    s_cmp_lg_u32 s3, 0
    s_cbranch_scc1 L_noold
    s_lshl_b32 s37, s41, 15
    s_lshl_b32 s38, s40, 11
    s_add_u32 s37, s37, s38
    buffer_load_dwordx4 v[100:103], v203, s[32:35], s37 offen sc1
    buffer_load_dwordx4 v[104:107], v203, s[32:35], s37 offen offset:1024 sc1
L_noold:
    s_setprio 0
    s_sub_i32 s44, s53, s45
    s_add_i32 s44, s44, 1
    s_sub_i32 s43, s52, s45
    s_add_i32 s43, s43, 1
    s_cmp_eq_u32 s54, s55
    s_cselect_b32 s44, s44, 0
    s_pack_ll_b32_b16 s69, s43, s44
    s_sub_i32 s44, s53, s47
    s_add_i32 s44, s44, 1
    s_sub_i32 s43, s52, s47
    s_add_i32 s43, s43, 1
    s_cmp_eq_u32 s56, s57
    s_cselect_b32 s44, s44, 0
    s_pack_ll_b32_b16 s68, s43, s44
    s_sub_i32 s44, s53, s48
    s_add_i32 s44, s44, 1
    s_lshl_b32 s67, s44, 16
    s_sub_i32 s44, s53, s46
    s_add_i32 s44, s44, 1
    s_lshl_b32 s66, s44, 16
    s_mov_b32 s77, s73
    s_add_u32 s76, s77, s72
    s_add_u32 s75, s76, s71
    v_lshl_or_b32 v9, v191, 8, v99
    v_add_u32 v9, s49, v9
    v_lshlrev_b32 v14, 2, v192
    v_xor_b32 v10, 64, v9
    v_xor_b32 v11, 128, v9
    v_xor_b32 v12, 192, v9
    v_and_b32 v18, 12, v0
    v_lshlrev_b32 v17, 6, v18
    v_lshl_add_u32 v17, v192, 4, v17
    v_add_u32 v17, 131584, v17
    v_lshlrev_b32 v201, 4, v18
    s_lshl_b32 s37, s3, 3
    s_add_u32 s37, s37, 131072
    v_add_u32 v201, s37, v201
    v_lshlrev_b32 v200, 6, v192
    v_add_u32 v200, 131072, v200
    v_and_b32 v13, 8, v0
    v_and_b32 v196, 32, v0
    v_lshlrev_b32 v196, 8, v196
    v_and_b32 v18, 16, v0
    v_lshl_or_b32 v196, v18, 4, v196
    v_and_b32 v18, 3, v0
    v_lshl_or_b32 v196, v18, 1, v196
    v_add_u32 v196, s36, v196
    v_lshl_or_b32 v205, v18, 6, v14
    v_and_b32 v18, 12, v0
    v_lshl_or_b32 v205, v18, 2, v205
    v_lshrrev_b32 v18, 2, v0
    v_and_b32 v206, 0x30, v203
    v_lshrrev_b32 v207, 1, v206
    v_lshl_or_b32 v206, v18, 11, v206
    v_lshl_or_b32 v207, v18, 7, v207
    s_lshr_b32 s43, s3, 1
    s_and_b32 s44, s3, 1
    s_lshl_b32 s43, s43, 8
    s_lshl_b32 s44, s44, 10
    s_add_u32 s43, s43, s44
    v_add_u32 v198, s43, v195
    v_add_u32 v199, 0x10000, v198
    v_add_u32 v197, s49, v203
    v_lshlrev_b32 v13, 1, v13
    v_and_b32 v18, 1, v0
    v_lshlrev_b32 v18, 4, v18
    v_mov_b32 v191, 0xffff
    v_lshlrev_b32 v191, v18, v191
    v_bfe_i32 v192, v0, 1, 1
    v_and_b32 v16, v191, v192
    v_xor_b32 v15, v191, v16
    v_mov_b32 v98, 0xff800000
    v_mov_b32 v96, 0x3f803f80
    v_mov_b32 v97, v96
    v_mov_b32 v84, 0
    v_mov_b32 v85, 0
    v_mov_b32 v86, 0
    v_mov_b32 v87, 0
    v_mov_b32 v88, 0
    v_mov_b32 v89, 0
    v_mov_b32 v90, 0
    v_mov_b32 v91, 0
    v_mov_b32 v92, 0
    v_mov_b32 v93, 0
    v_mov_b32 v94, 0
    v_mov_b32 v95, 0
    v_mov_b32 v193, 0xf149f2ca
    v_mov_b32 v202, 131328
    s_movk_i32 s59, 1023
    s_mov_b32 s36, 0x3e0293ee
    s_lshl_b32 s55, s41, 11
    s_add_u32 s55, s55, 524288
    s_lshl_b32 s54, s41, 15
    s_lshl_b32 s43, s40, 11
    s_add_u32 s56, s43, s54
    s_lshl_b32 s43, s3, 8
    s_add_u32 s56, s56, s43
    s_lshl_b32 s43, s40, 7
    s_add_u32 s57, s43, s55
    s_and_b32 s61, s3, 1
    s_lshl_b32 s61, s61, 6
    s_and_b32 s44, s40, 12
    s_lshl_b32 s44, s44, 4
    s_and_b32 s43, s40, 1
    s_lshl_b32 s43, s43, 5
    s_add_u32 s44, s44, s43
    s_and_b32 s43, s40, 2
    s_lshl_b32 s43, s43, 2
    s_add_u32 s44, s44, s43
    s_lshr_b32 s43, s61, 2
    s_add_u32 s44, s44, s43
    v_add_u32 v208, s44, v196
    s_lshl_b32 s60, s40, 7
    s_add_u32 s60, s60, s54
    s_add_u32 s60, s60, s61
    s_mov_b32 s58, 0x1000000
    s_min_i32 s43, s50, s51
    s_waitcnt vmcnt(0)
    ds_read_b128 v[20:23], v17 offset:0
    ds_read_b128 v[24:27], v17 offset:64
    ds_read_b128 v[28:31], v17 offset:128
    ds_read_b128 v[32:35], v17 offset:192
    s_cmp_eq_u32 s3, 0
    s_cbranch_scc1 L_epo0
L_epod:
    s_cmp_gt_i32 s43, 0
    s_cbranch_scc0 L_qzero
L_qok:
    s_cmp_eq_u32 s70, 0
    s_cbranch_scc1 L_qkskip0
    ds_read_b128 v[164:167], v9 offset:0
    ds_read_b128 v[168:171], v10 offset:0
    ds_read_b128 v[172:175], v11 offset:0
    ds_read_b128 v[176:179], v12 offset:0
    v_bfe_i32 v18, s66, v13, 16
    v_sub_u32 v18, v18, v14
    v_cmp_lt_i32 s[78:79], 0, v18
    v_cmp_lt_i32 s[80:81], 1, v18
    v_cmp_lt_i32 s[82:83], 2, v18
    v_cmp_lt_i32 s[84:85], 3, v18
    s_waitcnt lgkmcnt(3)
    v_mfma_f32_16x16x32_bf16 v[36:39], v[164:167], v[20:23], 0
    s_waitcnt lgkmcnt(2)
    v_mfma_f32_16x16x32_bf16 v[36:39], v[168:171], v[24:27], v[36:39]
    s_waitcnt lgkmcnt(1)
    v_mfma_f32_16x16x32_bf16 v[36:39], v[172:175], v[28:31], v[36:39]
    s_waitcnt lgkmcnt(0)
    v_mfma_f32_16x16x32_bf16 v[36:39], v[176:179], v[32:35], v[36:39]
    s_nop 7
    v_cndmask_b32 v36, v98, v36, s[78:79]
    v_cndmask_b32 v37, v98, v37, s[80:81]
    v_cndmask_b32 v38, v98, v38, s[82:83]
    v_cndmask_b32 v39, v98, v39, s[84:85]
    v_max3_f32 v193, v193, v36, v37
    v_max3_f32 v193, v193, v38, v39
L_qkskip0:
    s_cmp_eq_u32 s71, 0
    s_cbranch_scc1 L_qkskip1
    ds_read_b128 v[164:167], v9 offset:4096
    ds_read_b128 v[168:171], v10 offset:4096
    ds_read_b128 v[172:175], v11 offset:4096
    ds_read_b128 v[176:179], v12 offset:4096
    v_bfe_i32 v18, s67, v13, 16
    v_sub_u32 v18, v18, v14
    v_cmp_lt_i32 s[78:79], 0, v18
    v_cmp_lt_i32 s[80:81], 1, v18
    v_cmp_lt_i32 s[82:83], 2, v18
    v_cmp_lt_i32 s[84:85], 3, v18
    s_waitcnt lgkmcnt(3)
    v_mfma_f32_16x16x32_bf16 v[40:43], v[164:167], v[20:23], 0
    s_waitcnt lgkmcnt(2)
    v_mfma_f32_16x16x32_bf16 v[40:43], v[168:171], v[24:27], v[40:43]
    s_waitcnt lgkmcnt(1)
    v_mfma_f32_16x16x32_bf16 v[40:43], v[172:175], v[28:31], v[40:43]
    s_waitcnt lgkmcnt(0)
    v_mfma_f32_16x16x32_bf16 v[40:43], v[176:179], v[32:35], v[40:43]
    s_nop 7
    v_cndmask_b32 v40, v98, v40, s[78:79]
    v_cndmask_b32 v41, v98, v41, s[80:81]
    v_cndmask_b32 v42, v98, v42, s[82:83]
    v_cndmask_b32 v43, v98, v43, s[84:85]
    v_max3_f32 v193, v193, v40, v41
    v_max3_f32 v193, v193, v42, v43
L_qkskip1:
    s_cmp_eq_u32 s72, 0
    s_cbranch_scc1 L_qkskip2
    ds_read_b128 v[164:167], v9 offset:8192
    ds_read_b128 v[168:171], v10 offset:8192
    ds_read_b128 v[172:175], v11 offset:8192
    ds_read_b128 v[176:179], v12 offset:8192
    v_bfe_i32 v18, s68, v13, 16
    v_sub_u32 v18, v18, v14
    v_cmp_lt_i32 s[78:79], 0, v18
    v_cmp_lt_i32 s[80:81], 1, v18
    v_cmp_lt_i32 s[82:83], 2, v18
    v_cmp_lt_i32 s[84:85], 3, v18
    s_waitcnt lgkmcnt(3)
    v_mfma_f32_16x16x32_bf16 v[44:47], v[164:167], v[20:23], 0
    s_waitcnt lgkmcnt(2)
    v_mfma_f32_16x16x32_bf16 v[44:47], v[168:171], v[24:27], v[44:47]
    s_waitcnt lgkmcnt(1)
    v_mfma_f32_16x16x32_bf16 v[44:47], v[172:175], v[28:31], v[44:47]
    s_waitcnt lgkmcnt(0)
    v_mfma_f32_16x16x32_bf16 v[44:47], v[176:179], v[32:35], v[44:47]
    s_nop 7
    v_cndmask_b32 v44, v98, v44, s[78:79]
    v_cndmask_b32 v45, v98, v45, s[80:81]
    v_cndmask_b32 v46, v98, v46, s[82:83]
    v_cndmask_b32 v47, v98, v47, s[84:85]
    v_max3_f32 v193, v193, v44, v45
    v_max3_f32 v193, v193, v46, v47
L_qkskip2:
    s_cmp_eq_u32 s73, 0
    s_cbranch_scc1 L_qkskip3
    ds_read_b128 v[164:167], v9 offset:12288
    ds_read_b128 v[168:171], v10 offset:12288
    ds_read_b128 v[172:175], v11 offset:12288
    ds_read_b128 v[176:179], v12 offset:12288
    v_bfe_i32 v18, s69, v13, 16
    v_sub_u32 v18, v18, v14
    v_cmp_lt_i32 s[78:79], 0, v18
    v_cmp_lt_i32 s[80:81], 1, v18
    v_cmp_lt_i32 s[82:83], 2, v18
    v_cmp_lt_i32 s[84:85], 3, v18
    s_waitcnt lgkmcnt(3)
    v_mfma_f32_16x16x32_bf16 v[48:51], v[164:167], v[20:23], 0
    s_waitcnt lgkmcnt(2)
    v_mfma_f32_16x16x32_bf16 v[48:51], v[168:171], v[24:27], v[48:51]
    s_waitcnt lgkmcnt(1)
    v_mfma_f32_16x16x32_bf16 v[48:51], v[172:175], v[28:31], v[48:51]
    s_waitcnt lgkmcnt(0)
    v_mfma_f32_16x16x32_bf16 v[48:51], v[176:179], v[32:35], v[48:51]
    s_nop 7
    v_cndmask_b32 v48, v98, v48, s[78:79]
    v_cndmask_b32 v49, v98, v49, s[80:81]
    v_cndmask_b32 v50, v98, v50, s[82:83]
    v_cndmask_b32 v51, v98, v51, s[84:85]
    v_max3_f32 v193, v193, v48, v49
    v_max3_f32 v193, v193, v50, v51
L_qkskip3:
    s_cmp_eq_u32 s70, 0
    s_cbranch_scc1 L_vskip0
    buffer_load_dwordx4 v[100:103], v5, s[24:27], s62 offen nt
    buffer_load_dwordx4 v[104:107], v6, s[24:27], s62 offen nt
    buffer_load_dwordx4 v[108:111], v7, s[24:27], s62 offen nt
    buffer_load_dwordx4 v[112:115], v8, s[24:27], s62 offen nt
L_vskip0:
    s_cmp_eq_u32 s71, 0
    s_cbranch_scc1 L_vskip1
    buffer_load_dwordx4 v[116:119], v5, s[24:27], s63 offen nt
    buffer_load_dwordx4 v[120:123], v6, s[24:27], s63 offen nt
    buffer_load_dwordx4 v[124:127], v7, s[24:27], s63 offen nt
    buffer_load_dwordx4 v[128:131], v8, s[24:27], s63 offen nt
L_vskip1:
    s_cmp_eq_u32 s72, 0
    s_cbranch_scc1 L_vskip2
    buffer_load_dwordx4 v[132:135], v5, s[24:27], s64 offen nt
    buffer_load_dwordx4 v[136:139], v6, s[24:27], s64 offen nt
    buffer_load_dwordx4 v[140:143], v7, s[24:27], s64 offen nt
    buffer_load_dwordx4 v[144:147], v8, s[24:27], s64 offen nt
L_vskip2:
    s_cmp_eq_u32 s73, 0
    s_cbranch_scc1 L_vskip3
    buffer_load_dwordx4 v[148:151], v5, s[24:27], s65 offen nt
    buffer_load_dwordx4 v[152:155], v6, s[24:27], s65 offen nt
    buffer_load_dwordx4 v[156:159], v7, s[24:27], s65 offen nt
    buffer_load_dwordx4 v[160:163], v8, s[24:27], s65 offen nt
L_vskip3:
    v_mov_b32 v19, v193
    s_nop 1
    v_permlane16_swap_b32 v193, v19
    v_max_f32 v193, v193, v19
    v_mov_b32 v19, v193
    s_nop 1
    v_permlane32_swap_b32 v193, v19
    v_max_f32 v193, v193, v19
    v_mul_f32 v188, s36, v193
    s_cmp_eq_u32 s70, 0
    s_cbranch_scc1 L_pskip0
    v_fma_f32 v36, v36, s36, -v188
    v_fma_f32 v37, v37, s36, -v188
    v_fma_f32 v38, v38, s36, -v188
    v_fma_f32 v39, v39, s36, -v188
    v_exp_f32 v36, v36
    v_exp_f32 v37, v37
    v_exp_f32 v38, v38
    v_exp_f32 v39, v39
    s_nop 0
    v_cvt_pk_bf16_f32 v36, v36, v36
    v_cvt_pk_bf16_f32 v37, v37, v37
    v_cvt_pk_bf16_f32 v38, v38, v38
    v_cvt_pk_bf16_f32 v39, v39, v39
    v_and_b32 v52, v36, v15
    v_and_b32 v53, v36, v16
    v_and_b32 v54, v37, v15
    v_and_b32 v55, v37, v16
    v_and_b32 v56, v38, v15
    v_and_b32 v57, v38, v16
    v_and_b32 v58, v39, v15
    v_and_b32 v59, v39, v16
    s_nop 1
    v_mfma_f32_16x16x16_bf16 v[92:95], v[96:97], v[52:53], v[92:95]
    v_mfma_f32_16x16x16_bf16 v[92:95], v[96:97], v[54:55], v[92:95]
    v_mfma_f32_16x16x16_bf16 v[92:95], v[96:97], v[56:57], v[92:95]
    v_mfma_f32_16x16x16_bf16 v[92:95], v[96:97], v[58:59], v[92:95]
L_pskip0:
    s_cmp_eq_u32 s71, 0
    s_cbranch_scc1 L_pskip1
    v_fma_f32 v40, v40, s36, -v188
    v_fma_f32 v41, v41, s36, -v188
    v_fma_f32 v42, v42, s36, -v188
    v_fma_f32 v43, v43, s36, -v188
    v_exp_f32 v40, v40
    v_exp_f32 v41, v41
    v_exp_f32 v42, v42
    v_exp_f32 v43, v43
    s_nop 0
    v_cvt_pk_bf16_f32 v40, v40, v40
    v_cvt_pk_bf16_f32 v41, v41, v41
    v_cvt_pk_bf16_f32 v42, v42, v42
    v_cvt_pk_bf16_f32 v43, v43, v43
    v_and_b32 v60, v40, v15
    v_and_b32 v61, v40, v16
    v_and_b32 v62, v41, v15
    v_and_b32 v63, v41, v16
    v_and_b32 v64, v42, v15
    v_and_b32 v65, v42, v16
    v_and_b32 v66, v43, v15
    v_and_b32 v67, v43, v16
    s_nop 1
    v_mfma_f32_16x16x16_bf16 v[92:95], v[96:97], v[60:61], v[92:95]
    v_mfma_f32_16x16x16_bf16 v[92:95], v[96:97], v[62:63], v[92:95]
    v_mfma_f32_16x16x16_bf16 v[92:95], v[96:97], v[64:65], v[92:95]
    v_mfma_f32_16x16x16_bf16 v[92:95], v[96:97], v[66:67], v[92:95]
L_pskip1:
    s_cmp_eq_u32 s72, 0
    s_cbranch_scc1 L_pskip2
    v_fma_f32 v44, v44, s36, -v188
    v_fma_f32 v45, v45, s36, -v188
    v_fma_f32 v46, v46, s36, -v188
    v_fma_f32 v47, v47, s36, -v188
    v_exp_f32 v44, v44
    v_exp_f32 v45, v45
    v_exp_f32 v46, v46
    v_exp_f32 v47, v47
    s_nop 0
    v_cvt_pk_bf16_f32 v44, v44, v44
    v_cvt_pk_bf16_f32 v45, v45, v45
    v_cvt_pk_bf16_f32 v46, v46, v46
    v_cvt_pk_bf16_f32 v47, v47, v47
    v_and_b32 v68, v44, v15
    v_and_b32 v69, v44, v16
    v_and_b32 v70, v45, v15
    v_and_b32 v71, v45, v16
    v_and_b32 v72, v46, v15
    v_and_b32 v73, v46, v16
    v_and_b32 v74, v47, v15
    v_and_b32 v75, v47, v16
    s_nop 1
    v_mfma_f32_16x16x16_bf16 v[92:95], v[96:97], v[68:69], v[92:95]
    v_mfma_f32_16x16x16_bf16 v[92:95], v[96:97], v[70:71], v[92:95]
    v_mfma_f32_16x16x16_bf16 v[92:95], v[96:97], v[72:73], v[92:95]
    v_mfma_f32_16x16x16_bf16 v[92:95], v[96:97], v[74:75], v[92:95]
L_pskip2:
    s_cmp_eq_u32 s73, 0
    s_cbranch_scc1 L_pskip3
    v_fma_f32 v48, v48, s36, -v188
    v_fma_f32 v49, v49, s36, -v188
    v_fma_f32 v50, v50, s36, -v188
    v_fma_f32 v51, v51, s36, -v188
    v_exp_f32 v48, v48
    v_exp_f32 v49, v49
    v_exp_f32 v50, v50
    v_exp_f32 v51, v51
    s_nop 0
    v_cvt_pk_bf16_f32 v48, v48, v48
    v_cvt_pk_bf16_f32 v49, v49, v49
    v_cvt_pk_bf16_f32 v50, v50, v50
    v_cvt_pk_bf16_f32 v51, v51, v51
    v_and_b32 v76, v48, v15
    v_and_b32 v77, v48, v16
    v_and_b32 v78, v49, v15
    v_and_b32 v79, v49, v16
    v_and_b32 v80, v50, v15
    v_and_b32 v81, v50, v16
    v_and_b32 v82, v51, v15
    v_and_b32 v83, v51, v16
    s_nop 1
    v_mfma_f32_16x16x16_bf16 v[92:95], v[96:97], v[76:77], v[92:95]
    v_mfma_f32_16x16x16_bf16 v[92:95], v[96:97], v[78:79], v[92:95]
    v_mfma_f32_16x16x16_bf16 v[92:95], v[96:97], v[80:81], v[92:95]
    v_mfma_f32_16x16x16_bf16 v[92:95], v[96:97], v[82:83], v[92:95]
L_pskip3:
    v_min_u32 v188, -2, v188
    s_nop 6
    v_mov_b32 v189, v92
    s_mov_b64 exec, 0x1111
    ds_write_b64 v201, v[188:189]
    s_mov_b64 exec, -1
    s_mov_b32 s53, 0
    s_cmp_lg_u32 s3, 0
    s_cbranch_scc1 L_w1
    s_lshl_b32 s43, s41, 4
    s_load_dword s39, s[16:17], s43
L_w1:
    ds_read_b128 v[164:167], v200 offset:0
    ds_read_b128 v[168:171], v200 offset:16
    ds_read_b128 v[172:175], v200 offset:32
    ds_read_b128 v[176:179], v200 offset:48
    s_waitcnt lgkmcnt(0)
    v_max3_u32 v19, v164, v166, v168
    v_max3_f32 v18, v164, v166, v168
    v_max3_u32 v19, v19, v170, v172
    v_max3_f32 v18, v18, v170, v172
    v_max3_u32 v19, v19, v174, v176
    v_max3_f32 v18, v18, v174, v176
    v_max_u32 v19, v19, v178
    v_max_f32 v188, v18, v178
    v_cmp_eq_u32 vcc, -1, v19
    s_cmp_eq_u32 s53, 0
    s_cbranch_vccz L_w1ok
    s_cbranch_scc1 L_nomgr
    s_sleep 1
    s_branch L_w1
L_w1ok:
    v_sub_f32 v180, v164, v188
    v_sub_f32 v181, v166, v188
    v_sub_f32 v182, v168, v188
    v_sub_f32 v183, v170, v188
    v_sub_f32 v184, v172, v188
    v_sub_f32 v185, v174, v188
    v_sub_f32 v186, v176, v188
    v_sub_f32 v187, v178, v188
    v_exp_f32 v180, v180
    v_exp_f32 v181, v181
    v_exp_f32 v182, v182
    v_exp_f32 v183, v183
    v_exp_f32 v184, v184
    v_exp_f32 v185, v185
    v_exp_f32 v186, v186
    v_exp_f32 v187, v187
    s_mov_b32 s53, 1
    s_cbranch_scc0 L_fdone
L_nomgr:
    s_cmp_eq_u32 s70, 0
    s_cbranch_scc1 L_pvskip0
    s_waitcnt vmcnt(12)
    s_cmp_eq_u32 s75, 3
    s_cbranch_scc1 L_vwait0
    s_waitcnt vmcnt(8)
    s_cmp_eq_u32 s75, 2
    s_cbranch_scc1 L_vwait0
    s_waitcnt vmcnt(4)
    s_cmp_eq_u32 s75, 1
    s_cbranch_scc1 L_vwait0
    s_waitcnt vmcnt(0)
L_vwait0:
    v_mfma_f32_16x16x16_bf16 v[84:87], v[100:101], v[52:53], v[84:87]
    v_mfma_f32_16x16x16_bf16 v[88:91], v[102:103], v[52:53], v[88:91]
    v_mfma_f32_16x16x16_bf16 v[84:87], v[104:105], v[54:55], v[84:87]
    v_mfma_f32_16x16x16_bf16 v[88:91], v[106:107], v[54:55], v[88:91]
    v_mfma_f32_16x16x16_bf16 v[84:87], v[108:109], v[56:57], v[84:87]
    v_mfma_f32_16x16x16_bf16 v[88:91], v[110:111], v[56:57], v[88:91]
    v_mfma_f32_16x16x16_bf16 v[84:87], v[112:113], v[58:59], v[84:87]
    v_mfma_f32_16x16x16_bf16 v[88:91], v[114:115], v[58:59], v[88:91]
L_pvskip0:
    s_cmp_eq_u32 s71, 0
    s_cbranch_scc1 L_pvskip1
    s_waitcnt vmcnt(8)
    s_cmp_eq_u32 s76, 2
    s_cbranch_scc1 L_vwait1
    s_waitcnt vmcnt(4)
    s_cmp_eq_u32 s76, 1
    s_cbranch_scc1 L_vwait1
    s_waitcnt vmcnt(0)
L_vwait1:
    v_mfma_f32_16x16x16_bf16 v[84:87], v[116:117], v[60:61], v[84:87]
    v_mfma_f32_16x16x16_bf16 v[88:91], v[118:119], v[60:61], v[88:91]
    v_mfma_f32_16x16x16_bf16 v[84:87], v[120:121], v[62:63], v[84:87]
    v_mfma_f32_16x16x16_bf16 v[88:91], v[122:123], v[62:63], v[88:91]
    v_mfma_f32_16x16x16_bf16 v[84:87], v[124:125], v[64:65], v[84:87]
    v_mfma_f32_16x16x16_bf16 v[88:91], v[126:127], v[64:65], v[88:91]
    v_mfma_f32_16x16x16_bf16 v[84:87], v[128:129], v[66:67], v[84:87]
    v_mfma_f32_16x16x16_bf16 v[88:91], v[130:131], v[66:67], v[88:91]
L_pvskip1:
    s_cmp_eq_u32 s72, 0
    s_cbranch_scc1 L_pvskip2
    s_waitcnt vmcnt(4)
    s_cmp_eq_u32 s77, 1
    s_cbranch_scc1 L_vwait2
    s_waitcnt vmcnt(0)
L_vwait2:
    v_mfma_f32_16x16x16_bf16 v[84:87], v[132:133], v[68:69], v[84:87]
    v_mfma_f32_16x16x16_bf16 v[88:91], v[134:135], v[68:69], v[88:91]
    v_mfma_f32_16x16x16_bf16 v[84:87], v[136:137], v[70:71], v[84:87]
    v_mfma_f32_16x16x16_bf16 v[88:91], v[138:139], v[70:71], v[88:91]
    v_mfma_f32_16x16x16_bf16 v[84:87], v[140:141], v[72:73], v[84:87]
    v_mfma_f32_16x16x16_bf16 v[88:91], v[142:143], v[72:73], v[88:91]
    v_mfma_f32_16x16x16_bf16 v[84:87], v[144:145], v[74:75], v[84:87]
    v_mfma_f32_16x16x16_bf16 v[88:91], v[146:147], v[74:75], v[88:91]
L_pvskip2:
    s_cmp_eq_u32 s73, 0
    s_cbranch_scc1 L_pvskip3
    s_waitcnt vmcnt(3)
    v_mfma_f32_16x16x16_bf16 v[84:87], v[148:149], v[76:77], v[84:87]
    v_mfma_f32_16x16x16_bf16 v[88:91], v[150:151], v[76:77], v[88:91]
    s_waitcnt vmcnt(2)
    v_mfma_f32_16x16x16_bf16 v[84:87], v[152:153], v[78:79], v[84:87]
    v_mfma_f32_16x16x16_bf16 v[88:91], v[154:155], v[78:79], v[88:91]
    s_waitcnt vmcnt(1)
    v_mfma_f32_16x16x16_bf16 v[84:87], v[156:157], v[80:81], v[84:87]
    v_mfma_f32_16x16x16_bf16 v[88:91], v[158:159], v[80:81], v[88:91]
    s_waitcnt vmcnt(0)
    v_mfma_f32_16x16x16_bf16 v[84:87], v[160:161], v[82:83], v[84:87]
    v_mfma_f32_16x16x16_bf16 v[88:91], v[162:163], v[82:83], v[88:91]
L_pvskip3:
    s_cmp_eq_u32 s53, 0
    s_cselect_b32 s53, 2, 1
    s_cbranch_scc1 L_w1
L_fdone:
    s_cmp_eq_u32 s3, 0
    s_cbranch_scc1 L_mgr
    s_nop 1
L_dump:
    ds_write_b128 v197, v[84:87]
    ds_write_b128 v197, v[88:91] offset:1024
    s_waitcnt lgkmcnt(0)
    s_barrier
    ds_read_b32 v194, v202
    ds_read2st64_b32 v[164:165], v198 offset0:0 offset1:64
    ds_read2st64_b32 v[166:167], v198 offset0:128 offset1:192
    ds_read2st64_b32 v[168:169], v199 offset0:0 offset1:64
    ds_read2st64_b32 v[170:171], v199 offset0:128 offset1:192
    s_xor_b32 s44, s3, 0
    s_cmp_lt_u32 s44, 2
    s_cbranch_scc0 L_noearly
    buffer_load_dwordx2 v[104:105], v207, s[32:35], s55 offen sc1
L_noearly:
    s_waitcnt lgkmcnt(3)
    v_readfirstlane_b32 s39, v194
    v_mul_f32 v18, v180, v164
    v_mul_f32 v19, v181, v165
    s_waitcnt lgkmcnt(2)
    v_fmac_f32 v18, v182, v166
    v_fmac_f32 v19, v183, v167
    s_waitcnt lgkmcnt(1)
    v_fmac_f32 v18, v184, v168
    v_fmac_f32 v19, v185, v169
    s_lshr_b32 s39, s39, 16
    s_cmp_lg_u32 s39, s74
    s_waitcnt lgkmcnt(0)
    v_fmac_f32 v18, v186, v170
    v_fmac_f32 v19, v187, v171
    v_add_f32 v18, v18, v19
    v_bfi_b32 v191, s59, v194, v18
    s_cbranch_scc1 L_far
    buffer_store_dword v191, v205, s[32:35], s56 offen
L_stored:
    s_xor_b32 s44, s3, 0
    s_cmp_lt_u32 s44, 2
    s_cbranch_scc1 L_comb
L_fin:
L_end:
    s_endpgm
L_far:
    buffer_store_dword v191, v205, s[32:35], s56 offen sc1
    s_cmp_eq_u32 s40, 0
    s_cbranch_scc1 L_stored
    s_branch L_fin
.p2align 12
L_epo0:
    s_movk_i32 s1, 77
    v_and_b32 v100, s59, v100
    v_and_b32 v101, s59, v101
    v_and_b32 v102, s59, v102
    v_and_b32 v103, s59, v103
    v_and_b32 v104, s59, v104
    v_and_b32 v105, s59, v105
    v_and_b32 v106, s59, v106
    v_and_b32 v107, s59, v107
L_epo:
    s_add_u32 s1, s1, 400
    s_cmp_ge_u32 s1, s59
    s_cselect_b32 s0, s59, 0
    s_sub_u32 s1, s1, s0
    v_mov_b32 v18, 1
    v_xor_b32 v19, s1, v100
    v_xor_b32 v194, s1, v101
    v_min3_u32 v18, v18, v19, v194
    v_xor_b32 v19, s1, v102
    v_xor_b32 v194, s1, v103
    v_min3_u32 v18, v18, v19, v194
    v_xor_b32 v19, s1, v104
    v_xor_b32 v194, s1, v105
    v_min3_u32 v18, v18, v19, v194
    v_xor_b32 v19, s1, v106
    v_xor_b32 v194, s1, v107
    v_min3_u32 v18, v18, v19, v194
    v_cmp_eq_u32 vcc, 0, v18
    s_cbranch_vccnz L_epo
    s_branch L_epod
L_mgr:
    s_setprio 3
    v_mul_f32 v189, v180, v165
    v_fmac_f32 v189, v181, v167
    v_fmac_f32 v189, v182, v169
    v_fmac_f32 v189, v183, v171
    v_fmac_f32 v189, v184, v173
    v_fmac_f32 v189, v185, v175
    v_fmac_f32 v189, v186, v177
    v_fmac_f32 v189, v187, v179
    v_lshrrev_b32 v18, 1, v0
    v_min_u32 v188, -2, v188
    v_and_b32 v189, 0x7ffffc00, v189
    v_or_b32 v189, s1, v189
    s_mov_b32 exec_lo, 0x10001
    s_mov_b32 exec_hi, 0x10001
    s_cmp_eq_u32 s39, 0
    s_cbranch_scc1 L_tagwait
L_tagok:
    s_cmp_lg_u32 s39, s74
    s_cbranch_scc1 L_mfar
    buffer_store_dwordx2 v[188:189], v18, s[32:35], s57 offen
L_mdone:
    s_setprio 0
    s_lshl_b32 s43, s39, 16
    s_or_b32 s43, s43, s1
    v_mov_b32 v194, s43
    ds_write_b32 v202, v194
    s_mov_b64 exec, -1
    s_branch L_dump
L_comb:
    buffer_load_dwordx4 v[100:103], v206, s[32:35], s60 offen sc1
    s_waitcnt vmcnt(2)
L_pm:
    v_max_u32 v19, v104, v105
    v_cmp_eq_u32 vcc, -1, v19
    v_max_f32_dpp v18, v104, v104 row_ror:4 row_mask:0xf bank_mask:0xf
    s_cbranch_vccnz L_pmagain
    v_cmp_gt_i32 s[66:67], 0, v105
    v_max_f32_dpp v18, v18, v18 row_ror:8 row_mask:0xf bank_mask:0xf
    v_mov_b32 v19, v18
    s_nop 1
    v_permlane16_swap_b32 v18, v19
    v_max_f32 v18, v18, v19
    v_mov_b32 v19, v18
    s_nop 1
    v_permlane32_swap_b32 v18, v19
    v_max_f32 v18, v18, v19
    v_sub_f32 v106, v104, v18
    v_exp_f32 v106, v106
    buffer_load_dwordx4 v[100:103], v206, s[32:35], s60 offen sc1
    v_mul_f32 v109, v106, abs(v105)
    s_nop 1
    v_add_f32_dpp v109, v109, v109 row_ror:4 row_mask:0xf bank_mask:0xf
    s_nop 1
    v_add_f32_dpp v109, v109, v109 row_ror:8 row_mask:0xf bank_mask:0xf
    v_mov_b32 v110, v109
    s_nop 1
    v_permlane16_swap_b32 v109, v110
    v_add_f32 v109, v109, v110
    v_mov_b32 v110, v109
    s_nop 1
    v_permlane32_swap_b32 v109, v110
    v_add_f32 v109, v109, v110
    v_rcp_f32 v109, v109
    buffer_load_dwordx4 v[100:103], v206, s[32:35], s60 offen sc1
    v_mul_f32 v106, v106, v109
    s_waitcnt vmcnt(2)
L_chk2:
    v_xor_b32 v108, v100, v105
    v_mul_f32_dpp v112, v106, v100 quad_perm:[0,0,0,0] row_mask:0xf bank_mask:0xf
    v_bitop3_b32 v108, v108, v102, v105 bitop3:0xf6
    v_mul_f32_dpp v114, v106, v102 quad_perm:[2,2,2,2] row_mask:0xf bank_mask:0xf
    v_bitop3_b32 v108, v108, v101, v105 bitop3:0xf6
    v_mul_f32_dpp v113, v106, v101 quad_perm:[1,1,1,1] row_mask:0xf bank_mask:0xf
    v_bitop3_b32 v108, v108, v103, v105 bitop3:0xf6
    v_mul_f32_dpp v115, v106, v103 quad_perm:[3,3,3,3] row_mask:0xf bank_mask:0xf
    v_and_b32 v108, s59, v108
    v_permlane32_swap_b32 v112, v114
    v_cmp_ne_u32 vcc, 0, v108
    v_permlane32_swap_b32 v113, v115
    s_cbranch_vccnz L_again
    v_pk_add_f32 v[112:113], v[112:113], v[114:115]
    s_nop 1
    v_permlane16_swap_b32 v112, v113
    v_add_f32 v112, v112, v113
    s_nop 1
    v_add_f32_dpp v112, v112, v112 row_ror:4 row_mask:0xf bank_mask:0xf
    s_nop 1
    v_add_f32_dpp v112, v112, v112 row_ror:8 row_mask:0xf bank_mask:0xf
    s_mov_b32 exec_lo, 0x000f000f
    s_mov_b32 exec_hi, 0x000f000f
    v_cvt_pk_bf16_f32 v109, v112, v112
    global_store_short v208, v109, s[14:15]
    s_cmp_lg_u32 s40, 0
    s_cbranch_scc1 L_fin
    s_mov_b64 exec, -1
    s_andn2_b32 s66, s66, 15
    s_cmp_eq_u64 s[66:67], 0
    s_cbranch_scc1 L_fin
    s_ff1_i32_b64 s43, s[66:67]
    s_lshr_b32 s62, s43, 2
    s_and_b32 s43, s43, 60
    s_lshl_b64 vcc, 15, s43
    s_andn2_b64 s[66:67], s[66:67], vcc
    s_and_b32 s64, s62, 12
    s_lshl_b32 s64, s64, 4
    s_and_b32 s43, s62, 1
    s_lshl_b32 s43, s43, 5
    s_add_u32 s64, s64, s43
    s_and_b32 s43, s62, 2
    s_lshl_b32 s43, s43, 2
    s_add_u32 s64, s64, s43
    s_lshr_b32 s43, s61, 2
    s_add_u32 s64, s64, s43
    v_add_u32 v208, s64, v196
    s_lshl_b32 s60, s62, 7
    s_add_u32 s60, s60, s54
    s_add_u32 s60, s60, s61
    buffer_load_dwordx4 v[100:103], v206, s[32:35], s60 offen sc1
    s_waitcnt vmcnt(0)
    s_branch L_chk2
L_again:
    s_mov_b64 exec, vcc
    s_bcnt1_i32_b64 s43, vcc
    s_cmp_le_u32 s43, 16
    s_cbranch_scc1 L_nosl
    s_sleep 2
L_nosl:
    buffer_load_dwordx4 v[100:103], v206, s[32:35], s60 offen sc1
    s_mov_b64 exec, -1
    s_sub_u32 s58, s58, 0x21
    s_waitcnt vmcnt(2)
    s_cbranch_scc0 L_chk2
    s_branch L_fin
L_pmagain:
    s_mov_b64 exec, vcc
    s_sleep 2
    buffer_load_dwordx2 v[104:105], v207, s[32:35], s55 offen sc1
    s_mov_b64 exec, -1
    s_sub_u32 s58, s58, 0x100
    s_cbranch_scc1 L_fin
    s_waitcnt vmcnt(0)
    s_branch L_pm
L_mfar:
    v_or_b32 v189, 0x80000000, v189
    buffer_store_dwordx2 v[188:189], v18, s[32:35], s57 offen sc1
    s_branch L_mdone
L_tagwait:
    global_load_dword v194, v190, s[16:17] sc1
    s_sub_u32 s58, s58, 0x100
    s_cbranch_scc1 L_fin
    s_waitcnt vmcnt(0)
    v_readfirstlane_b32 s39, v194
    s_nop 3
    s_cmp_lg_u32 s39, 0
    s_cbranch_scc1 L_tagok
    s_sleep 4
    s_branch L_tagwait
L_qzero:
    s_cmp_gt_i32 s50, 0
    s_cselect_b32 s43, 0, 0x00ff00ff
    s_cmp_gt_i32 s51, 0
    s_cselect_b32 s37, 0, 0xff00ff00
    s_waitcnt lgkmcnt(0)
    s_or_b32 exec_lo, s43, s37
    s_mov_b32 exec_hi, exec_lo
    v_mov_b32 v20, 0
    v_mov_b32 v21, 0
    v_mov_b32 v22, 0
    v_mov_b32 v23, 0
    v_mov_b32 v24, 0
    v_mov_b32 v25, 0
    v_mov_b32 v26, 0
    v_mov_b32 v27, 0
    v_mov_b32 v28, 0
    v_mov_b32 v29, 0
    v_mov_b32 v30, 0
    v_mov_b32 v31, 0
    v_mov_b32 v32, 0
    v_mov_b32 v33, 0
    v_mov_b32 v34, 0
    v_mov_b32 v35, 0
    s_mov_b64 exec, -1
    s_branch L_qok
.section .rodata,"a"
.p2align 6
.amdhsa_kernel standalone__paged_block_table_kv_radixattention__decode_kernel
  .amdhsa_next_free_vgpr 216
  .amdhsa_next_free_sgpr 102
  .amdhsa_accum_offset 216
  .amdhsa_group_segment_fixed_size 0
  .amdhsa_kernarg_size 64
  .amdhsa_user_sgpr_count 2
  .amdhsa_user_sgpr_kernarg_segment_ptr 1
  .amdhsa_system_sgpr_workgroup_id_x 1
.end_amdhsa_kernel
```
